```python
import torch

def _softmax(x, axis=-1):
    return torch.softmax(x, dim=axis)
def _gelu(x):
    return torch.nn.functional.gelu(x, approximate="tanh")
def _silu(x):
    return torch.nn.functional.silu(x)
def _sigmoid(x):
    return torch.sigmoid(x)
def _layernorm(x, axis=-1, eps=1e-5):
    m = x.mean(dim=axis, keepdim=True)
    v = x.var(dim=axis, keepdim=True, unbiased=False)
    return (x - m) / torch.sqrt(v + eps)
def _scatter_add(tgt, idx, src, axis=0):
    return tgt.clone().index_add_(axis, idx, src)
def _segment_sum(src, seg, n):
    out = torch.zeros((n,) + src.shape[1:], dtype=src.dtype)
    return out.index_add_(0, seg, src)
def _pad(x, pw):
    flat = tuple(v for pair in reversed(pw) for v in pair)
    return torch.nn.functional.pad(x, flat)

kernel_name = 'standalone__rmsnorm__sampling'

def setup_inputs():

    _w = (lambda a: (lambda t: t.to(torch.bfloat16) if t.is_floating_point() else t)(torch.as_tensor(a)))
    B, S, D = 1024, 16, 512
    return {
        "x": _w((lambda *s: torch.randn(*s, dtype=torch.bfloat16) * 0.05)(B, S, D)),
        "g": _w((lambda *s: torch.randn(*s, dtype=torch.bfloat16) * 0.05)(D) + 1.0),
    }

def reference(x, g):
    rms = torch.sqrt((x * x).mean(axis=-1, keepdims=True) + 1e-6)
    return x / rms * g
```

```asm
; @launch grid=(256,1,1) block=(1024,1,1) lds=0
.amdgcn_target "amdgcn-amd-amdhsa--gfx950"
.text
.p2align 12
.globl standalone__rmsnorm__sampling_kernel
.p2align 8
.type standalone__rmsnorm__sampling_kernel,@function

.macro ROW x
    v_mov_b32 v28, 0
    v_dot2c_f32_bf16 v28, v[\x], v[\x]
    v_dot2c_f32_bf16 v28, v[\x+1], v[\x+1]
    v_dot2c_f32_bf16 v28, v[\x+2], v[\x+2]
    v_dot2c_f32_bf16 v28, v[\x+3], v[\x+3]
    v_lshlrev_b32 v20, 16, v[\x]
    v_and_b32 v21, s0, v[\x]
    v_lshlrev_b32 v22, 16, v[\x+1]
    v_add_f32_dpp v28, v28, v28 row_shr:1 row_mask:0xf bank_mask:0xf bound_ctrl:0
    v_and_b32 v23, s0, v[\x+1]
    v_lshlrev_b32 v24, 16, v[\x+2]
    v_add_f32_dpp v28, v28, v28 row_shr:2 row_mask:0xf bank_mask:0xf bound_ctrl:0
    v_and_b32 v25, s0, v[\x+2]
    v_lshlrev_b32 v26, 16, v[\x+3]
    v_add_f32_dpp v28, v28, v28 row_shr:4 row_mask:0xf bank_mask:0xf bound_ctrl:0
    v_and_b32 v27, s0, v[\x+3]
    v_pk_mul_f32 v[20:21], v[20:21], v[12:13]
    v_add_f32_dpp v28, v28, v28 row_shr:8 row_mask:0xf bank_mask:0xf bound_ctrl:0
    v_pk_mul_f32 v[22:23], v[22:23], v[14:15]
    v_pk_mul_f32 v[24:25], v[24:25], v[16:17]
    v_add_f32_dpp v28, v28, v28 row_bcast:15 row_mask:0xa bank_mask:0xf
    v_pk_mul_f32 v[26:27], v[26:27], v[18:19]
    s_nop 0
    v_add_f32_dpp v28, v28, v28 row_bcast:31 row_mask:0xc bank_mask:0xf
    v_fma_f32 v28, v28, s1, v29
    v_rsq_f32 v28, v28
    s_nop 0
    v_readlane_b32 s36, v28, 63
    s_nop 1
    v_pk_mul_f32 v[20:21], v[20:21], s[36:37] op_sel_hi:[1,0]
    v_pk_mul_f32 v[22:23], v[22:23], s[36:37] op_sel_hi:[1,0]
    v_pk_mul_f32 v[24:25], v[24:25], s[36:37] op_sel_hi:[1,0]
    v_pk_mul_f32 v[26:27], v[26:27], s[36:37] op_sel_hi:[1,0]
    v_cvt_pk_bf16_f32 v[\x], v20, v21
    v_cvt_pk_bf16_f32 v[\x+1], v22, v23
    v_cvt_pk_bf16_f32 v[\x+2], v24, v25
    v_cvt_pk_bf16_f32 v[\x+3], v26, v27
.endm

standalone__rmsnorm__sampling_kernel:
    s_load_dwordx8 s[4:11], s[0:1], 0
    s_memrealtime s[26:27]
    v_readfirstlane_b32 s12, v0
    s_getreg_b32 s18, hwreg(HW_REG_XCC_ID, 0, 3)
    v_and_b32 v1, 63, v0
    s_lshl_b32 s15, s12, 2
    s_or_b32 s15, s15, s2
    s_and_b32 s16, s15, 0x338
    s_lshl_b32 s16, s16, 7
    s_and_b32 s14, s15, 0x840
    s_lshl_b32 s14, s14, 8
    s_or_b32 s16, s16, s14
    s_and_b32 s14, s15, 0x404
    s_lshl_b32 s14, s14, 11
    s_or_b32 s16, s16, s14
    s_and_b32 s14, s15, 0x80
    s_lshl_b32 s14, s14, 13
    s_or_b32 s16, s16, s14
    s_and_b32 s14, s15, 0x3
    s_lshl_b32 s14, s14, 17
    s_or_b32 s16, s16, s14
    v_lshlrev_b32 v1, 4, v1
    s_and_b32 s20, s18, 4
    s_lshl_b32 s20, s20, 7
    s_or_b32 s20, s20, 0xc00000
    v_or_b32 v2, s16, v1
    s_cmpk_ge_u32 s2, 256
    s_cbranch_scc1 L_done
    s_mov_b32 s24, -16
    s_waitcnt lgkmcnt(0)
    s_and_b32 s27, s26, 0x7f000
    s_and_b32 s26, s26, 0x7fe00
    s_add_u32 s26, s26, s27
    s_lshl1_add_u32 s20, s26, s20
    s_load_dword s24, s[4:5], s20
    s_load_dword s25, s[4:5], s20 offset:0x2040
    global_load_dwordx4 v[4:7], v2, s[4:5] nt
    global_load_dwordx4 v[24:27], v1, s[6:7]
    s_mov_b32 s0, 0xffff0000
    s_mov_b32 s1, 0x3b000000
    v_mov_b32 v29, 0x358637bd
    s_lshr_b32 s14, s16, 8
    s_xor_b32 s14, s14, s16
    s_and_b32 s14, s14, 0x2000
    s_bitset1_b32 s14, 22
    s_xor_b32 s16, s16, s14
    s_and_b32 s18, s18, 3
    s_sub_u32 s18, s18, s2
    s_mov_b32 s13, 0
    s_mov_b32 s35, 0
    s_waitcnt lgkmcnt(1)
    s_cmp_lg_u32 s24, -16
    s_cselect_b32 s17, 0, 4
    s_add_u32 s34, s18, s17
    s_or_b32 s34, s34, 8
    s_cmp_ge_u32 s15, 8
    s_cbranch_scc1 L_go
    s_atomic_cmpswap s[34:35], s[10:11], 0
L_go:
    s_lshl_b32 s14, s17, 11
    s_xor_b32 s14, s14, s16
    v_or_b32 v3, s14, v1
    s_waitcnt vmcnt(1)
    global_load_dwordx4 v[8:11], v3, s[4:5] nt
    s_waitcnt vmcnt(1)
    v_lshlrev_b32 v12, 16, v24
    v_and_b32 v13, s0, v24
    v_lshlrev_b32 v14, 16, v25
    v_and_b32 v15, s0, v25
    v_lshlrev_b32 v16, 16, v26
    v_and_b32 v17, s0, v26
    v_lshlrev_b32 v18, 16, v27
    v_and_b32 v19, s0, v27
L_pass:
    ROW 4
    global_store_dwordx4 v2, v[4:7], s[8:9] sc1
    s_cmp_lg_u32 s13, 0
    s_cbranch_scc1 L_last
    s_cmpk_lt_u32 s12, 512
    s_cbranch_scc1 L_nord
    s_load_dword s3, s[10:11], 0
L_nord:
    v_xor_b32 v2, 0xc00000, v3
    s_waitcnt vmcnt(1)
    s_load_dword s3, s[10:11], 0
    s_waitcnt lgkmcnt(0)
    s_cmp_eq_u32 s3, 0
    s_cbranch_scc1 L_poll
L_have:
    s_add_u32 s3, s3, s2
    s_xor_b32 s3, s3, s17
    s_and_b32 s3, s3, 4
    s_cbranch_scc1 L_flip
    global_load_dwordx4 v[4:7], v2, s[4:5] nt
    s_branch L_rowb
L_flip:
    s_lshl_b32 s3, s3, 11
    v_xor_b32 v3, s3, v3
    v_xor_b32 v2, s3, v2
    global_load_dwordx4 v[8:11], v3, s[4:5] nt
    global_load_dwordx4 v[4:7], v2, s[4:5] nt
L_last:
    s_waitcnt vmcnt(1)
L_rowb:
    ROW 8
    global_store_dwordx4 v3, v[8:11], s[8:9] sc1
    s_cmp_lg_u32 s13, 0
    s_cbranch_scc1 L_done
    s_mov_b32 s13, 1
    v_xor_b32 v3, 0x400000, v2
    s_waitcnt vmcnt(1)
    global_load_dwordx4 v[8:11], v3, s[4:5] nt
    s_branch L_pass
L_done:
    s_endpgm

L_poll:
    s_mov_b32 s22, 64
    v_mov_b32 v20, 0
L_poll1:
    global_load_dword v28, v20, s[10:11] sc1
    s_waitcnt vmcnt(0)
    v_readfirstlane_b32 s3, v28
    s_cmp_lg_u32 s3, 0
    s_cbranch_scc1 L_have
    s_sub_u32 s22, s22, 1
    s_cmp_lg_u32 s22, 0
    s_cbranch_scc1 L_poll1
    s_mov_b32 s20, s34
    s_mov_b32 s21, 0
    s_atomic_cmpswap s[20:21], s[10:11], 0 glc
    s_waitcnt lgkmcnt(0)
    s_cmp_eq_u32 s20, 0
    s_cselect_b32 s3, s34, s20
    s_branch L_have
.section .rodata,"a"
.p2align 6
.amdhsa_kernel standalone__rmsnorm__sampling_kernel
  .amdhsa_next_free_vgpr 30
  .amdhsa_next_free_sgpr 40
  .amdhsa_accum_offset 32
  .amdhsa_group_segment_fixed_size 0
  .amdhsa_kernarg_size 40
  .amdhsa_user_sgpr_count 2
  .amdhsa_user_sgpr_kernarg_segment_ptr 1
  .amdhsa_system_sgpr_workgroup_id_x 1
  .amdhsa_float_denorm_mode_32 3
.end_amdhsa_kernel
```

```asm
; @launch grid=(256,1,1) block=(1024,1,1) lds=0
.amdgcn_target "amdgcn-amd-amdhsa--gfx950"
.text
.p2align 12
.globl standalone__rmsnorm__sampling_kernel
.p2align 8
.type standalone__rmsnorm__sampling_kernel,@function

.macro ROW x
    v_mov_b32 v28, 0
    v_dot2c_f32_bf16 v28, v[\x], v[\x]
    v_dot2c_f32_bf16 v28, v[\x+1], v[\x+1]
    v_dot2c_f32_bf16 v28, v[\x+2], v[\x+2]
    v_dot2c_f32_bf16 v28, v[\x+3], v[\x+3]
    v_lshlrev_b32 v20, 16, v[\x]
    v_and_b32 v21, s0, v[\x]
    v_lshlrev_b32 v22, 16, v[\x+1]
    v_add_f32_dpp v28, v28, v28 row_shr:1 row_mask:0xf bank_mask:0xf bound_ctrl:0
    v_and_b32 v23, s0, v[\x+1]
    v_lshlrev_b32 v24, 16, v[\x+2]
    v_add_f32_dpp v28, v28, v28 row_shr:2 row_mask:0xf bank_mask:0xf bound_ctrl:0
    v_and_b32 v25, s0, v[\x+2]
    v_lshlrev_b32 v26, 16, v[\x+3]
    v_add_f32_dpp v28, v28, v28 row_shr:4 row_mask:0xf bank_mask:0xf bound_ctrl:0
    v_and_b32 v27, s0, v[\x+3]
    v_pk_mul_f32 v[20:21], v[20:21], v[12:13]
    v_add_f32_dpp v28, v28, v28 row_shr:8 row_mask:0xf bank_mask:0xf bound_ctrl:0
    v_pk_mul_f32 v[22:23], v[22:23], v[14:15]
    v_pk_mul_f32 v[24:25], v[24:25], v[16:17]
    v_add_f32_dpp v28, v28, v28 row_bcast:15 row_mask:0xa bank_mask:0xf
    v_pk_mul_f32 v[26:27], v[26:27], v[18:19]
    s_nop 0
    v_add_f32_dpp v28, v28, v28 row_bcast:31 row_mask:0xc bank_mask:0xf
    v_fma_f32 v28, v28, s1, v29
    v_rsq_f32 v28, v28
    s_nop 0
    v_readlane_b32 s36, v28, 63
    s_nop 1
    v_pk_mul_f32 v[20:21], v[20:21], s[36:37] op_sel_hi:[1,0]
    v_pk_mul_f32 v[22:23], v[22:23], s[36:37] op_sel_hi:[1,0]
    v_pk_mul_f32 v[24:25], v[24:25], s[36:37] op_sel_hi:[1,0]
    v_pk_mul_f32 v[26:27], v[26:27], s[36:37] op_sel_hi:[1,0]
    v_cvt_pk_bf16_f32 v[\x], v20, v21
    v_cvt_pk_bf16_f32 v[\x+1], v22, v23
    v_cvt_pk_bf16_f32 v[\x+2], v24, v25
    v_cvt_pk_bf16_f32 v[\x+3], v26, v27
.endm

standalone__rmsnorm__sampling_kernel:
    s_load_dwordx8 s[4:11], s[0:1], 0
    s_memrealtime s[26:27]
    v_readfirstlane_b32 s12, v0
    s_getreg_b32 s18, hwreg(HW_REG_XCC_ID, 0, 3)
    v_and_b32 v1, 63, v0
    s_lshl2_add_u32 s15, s12, s2
    s_and_b32 s16, s15, 0x70
    s_lshl_b32 s16, s16, 6
    s_and_b32 s14, s15, 0x380
    s_lshl_b32 s14, s14, 7
    s_or_b32 s16, s16, s14
    s_and_b32 s14, s15, 0xc00
    s_lshl_b32 s14, s14, 9
    s_or_b32 s16, s16, s14
    s_and_b32 s14, s15, 0x4
    s_lshl_b32 s14, s14, 11
    s_or_b32 s16, s16, s14
    s_and_b32 s14, s15, 0x3
    s_lshl_b32 s14, s14, 17
    s_or_b32 s16, s16, s14
    s_and_b32 s14, s15, 0x8
    s_lshl_b32 s14, s14, 18
    s_or_b32 s16, s16, s14
    v_lshlrev_b32 v1, 4, v1
    s_and_b32 s20, s18, 4
    s_lshl_b32 s20, s20, 7
    s_or_b32 s20, s20, 0xc00000
    v_or_b32 v2, s16, v1
    s_cmpk_ge_u32 s2, 256
    s_cbranch_scc1 L_done
    s_mov_b32 s24, -16
    s_waitcnt lgkmcnt(0)
    s_and_b32 s27, s26, 0x7f000
    s_and_b32 s26, s26, 0x7fe00
    s_add_u32 s26, s26, s27
    s_lshl1_add_u32 s20, s26, s20
    s_load_dword s24, s[4:5], s20
    s_load_dword s25, s[4:5], s20 offset:0x2040
    global_load_dwordx4 v[4:7], v2, s[4:5] nt
    global_load_dwordx4 v[24:27], v1, s[6:7]
    s_mov_b32 s0, 0xffff0000
    s_mov_b32 s1, 0x3b000000
    v_mov_b32 v29, 0x358637bd
    s_lshr_b32 s14, s16, 8
    s_xor_b32 s14, s14, s16
    s_and_b32 s14, s14, 0x2000
    s_bitset1_b32 s14, 22
    s_xor_b32 s16, s16, s14
    s_and_b32 s18, s18, 3
    s_sub_u32 s18, s18, s2
    s_mov_b32 s13, 0
    s_mov_b32 s35, 0
    s_waitcnt lgkmcnt(1)
    s_cmp_lg_u32 s24, -16
    s_cselect_b32 s17, 0, 4
    s_add_u32 s34, s18, s17
    s_or_b32 s34, s34, 8
    s_cmp_ge_u32 s15, 8
    s_cbranch_scc1 L_go
    s_atomic_cmpswap s[34:35], s[10:11], 0
L_go:
    s_lshl_b32 s14, s17, 11
    s_xor_b32 s14, s14, s16
    v_or_b32 v3, s14, v1
    s_waitcnt vmcnt(1)
    global_load_dwordx4 v[8:11], v3, s[4:5] nt
    s_waitcnt vmcnt(1)
    v_lshlrev_b32 v12, 16, v24
    v_and_b32 v13, s0, v24
    v_lshlrev_b32 v14, 16, v25
    v_and_b32 v15, s0, v25
    v_lshlrev_b32 v16, 16, v26
    v_and_b32 v17, s0, v26
    v_lshlrev_b32 v18, 16, v27
    v_and_b32 v19, s0, v27
L_pass:
    ROW 4
    global_store_dwordx4 v2, v[4:7], s[8:9] sc1
    s_cmp_lg_u32 s13, 0
    s_cbranch_scc1 L_last
    v_xor_b32 v2, 0xc00000, v3
    s_waitcnt vmcnt(1)
    s_load_dword s3, s[10:11], 0
    s_waitcnt lgkmcnt(0)
    s_cmp_eq_u32 s3, 0
    s_cbranch_scc1 L_poll
L_have:
    s_add_u32 s3, s3, s2
    s_xor_b32 s3, s3, s17
    s_and_b32 s3, s3, 4
    s_cbranch_scc1 L_flip
    global_load_dwordx4 v[4:7], v2, s[4:5] nt
    s_branch L_rowb
L_flip:
    s_lshl_b32 s3, s3, 11
    v_xor_b32 v3, s3, v3
    v_xor_b32 v2, s3, v2
    global_load_dwordx4 v[8:11], v3, s[4:5] nt
    global_load_dwordx4 v[4:7], v2, s[4:5] nt
L_last:
    s_waitcnt vmcnt(1)
L_rowb:
    ROW 8
    global_store_dwordx4 v3, v[8:11], s[8:9] sc1
    s_cmp_lg_u32 s13, 0
    s_cbranch_scc1 L_done
    s_mov_b32 s13, 1
    v_xor_b32 v3, 0x400000, v2
    s_waitcnt vmcnt(1)
    global_load_dwordx4 v[8:11], v3, s[4:5] nt
    s_branch L_pass
L_done:
    s_endpgm

L_poll:
    s_mov_b32 s22, 64
    v_mov_b32 v20, 0
L_poll1:
    global_load_dword v28, v20, s[10:11] sc1
    s_waitcnt vmcnt(0)
    v_readfirstlane_b32 s3, v28
    s_cmp_lg_u32 s3, 0
    s_cbranch_scc1 L_have
    s_sub_u32 s22, s22, 1
    s_cmp_lg_u32 s22, 0
    s_cbranch_scc1 L_poll1
    s_mov_b32 s20, s34
    s_mov_b32 s21, 0
    s_atomic_cmpswap s[20:21], s[10:11], 0 glc
    s_waitcnt lgkmcnt(0)
    s_cmp_eq_u32 s20, 0
    s_cselect_b32 s3, s34, s20
    s_branch L_have
.section .rodata,"a"
.p2align 6
.amdhsa_kernel standalone__rmsnorm__sampling_kernel
  .amdhsa_next_free_vgpr 30
  .amdhsa_next_free_sgpr 40
  .amdhsa_accum_offset 32
  .amdhsa_group_segment_fixed_size 0
  .amdhsa_kernarg_size 40
  .amdhsa_user_sgpr_count 2
  .amdhsa_user_sgpr_kernarg_segment_ptr 1
  .amdhsa_system_sgpr_workgroup_id_x 1
  .amdhsa_float_denorm_mode_32 3
.end_amdhsa_kernel
```

```asm
; @launch grid=(256,1,1) block=(1024,1,1) lds=0
.amdgcn_target "amdgcn-amd-amdhsa--gfx950"
.text
.p2align 12
.globl standalone__rmsnorm__sampling_kernel
.p2align 8
.type standalone__rmsnorm__sampling_kernel,@function

.macro ROW x
    v_mov_b32 v28, 0
    v_dot2c_f32_bf16 v28, v[\x], v[\x]
    v_dot2c_f32_bf16 v28, v[\x+1], v[\x+1]
    v_dot2c_f32_bf16 v28, v[\x+2], v[\x+2]
    v_dot2c_f32_bf16 v28, v[\x+3], v[\x+3]
    v_lshlrev_b32 v20, 16, v[\x]
    v_and_b32 v21, s0, v[\x]
    v_lshlrev_b32 v22, 16, v[\x+1]
    v_add_f32_dpp v28, v28, v28 row_shr:1 row_mask:0xf bank_mask:0xf bound_ctrl:0
    v_and_b32 v23, s0, v[\x+1]
    v_lshlrev_b32 v24, 16, v[\x+2]
    v_add_f32_dpp v28, v28, v28 row_shr:2 row_mask:0xf bank_mask:0xf bound_ctrl:0
    v_and_b32 v25, s0, v[\x+2]
    v_lshlrev_b32 v26, 16, v[\x+3]
    v_add_f32_dpp v28, v28, v28 row_shr:4 row_mask:0xf bank_mask:0xf bound_ctrl:0
    v_and_b32 v27, s0, v[\x+3]
    v_pk_mul_f32 v[20:21], v[20:21], v[12:13]
    v_add_f32_dpp v28, v28, v28 row_shr:8 row_mask:0xf bank_mask:0xf bound_ctrl:0
    v_pk_mul_f32 v[22:23], v[22:23], v[14:15]
    v_pk_mul_f32 v[24:25], v[24:25], v[16:17]
    v_add_f32_dpp v28, v28, v28 row_bcast:15 row_mask:0xa bank_mask:0xf
    v_pk_mul_f32 v[26:27], v[26:27], v[18:19]
    s_nop 0
    v_add_f32_dpp v28, v28, v28 row_bcast:31 row_mask:0xc bank_mask:0xf
    v_fma_f32 v28, v28, s1, v29
    v_rsq_f32 v28, v28
    s_nop 0
    v_readlane_b32 s36, v28, 63
    s_nop 1
    v_pk_mul_f32 v[20:21], v[20:21], s[36:37] op_sel_hi:[1,0]
    v_pk_mul_f32 v[22:23], v[22:23], s[36:37] op_sel_hi:[1,0]
    v_pk_mul_f32 v[24:25], v[24:25], s[36:37] op_sel_hi:[1,0]
    v_pk_mul_f32 v[26:27], v[26:27], s[36:37] op_sel_hi:[1,0]
    v_cvt_pk_bf16_f32 v[\x], v20, v21
    v_cvt_pk_bf16_f32 v[\x+1], v22, v23
    v_cvt_pk_bf16_f32 v[\x+2], v24, v25
    v_cvt_pk_bf16_f32 v[\x+3], v26, v27
.endm

standalone__rmsnorm__sampling_kernel:
    s_load_dwordx8 s[4:11], s[0:1], 0
    s_memrealtime s[26:27]
    v_readfirstlane_b32 s12, v0
    s_getreg_b32 s18, hwreg(HW_REG_XCC_ID, 0, 3)
    v_and_b32 v1, 63, v0
    s_lshl2_add_u32 s15, s12, s2
    s_and_b32 s16, s15, 0x70
    s_lshl_b32 s16, s16, 6
    s_and_b32 s14, s15, 0x380
    s_lshl_b32 s14, s14, 7
    s_or_b32 s16, s16, s14
    s_and_b32 s14, s15, 0xc00
    s_lshl_b32 s14, s14, 9
    s_or_b32 s16, s16, s14
    s_and_b32 s14, s15, 0x4
    s_lshl_b32 s14, s14, 11
    s_or_b32 s16, s16, s14
    s_and_b32 s14, s15, 0x3
    s_lshl_b32 s14, s14, 17
    s_or_b32 s16, s16, s14
    s_and_b32 s14, s15, 0x8
    s_lshl_b32 s14, s14, 18
    s_or_b32 s16, s16, s14
    v_lshlrev_b32 v1, 4, v1
    s_and_b32 s20, s18, 4
    s_lshl_b32 s20, s20, 7
    s_or_b32 s20, s20, 0xc00000
    v_or_b32 v2, s16, v1
    s_cmpk_ge_u32 s2, 256
    s_cbranch_scc1 L_done
    s_mov_b32 s24, -16
    s_waitcnt lgkmcnt(0)
    s_and_b32 s19, s4, 0x1ffc00
    s_cbranch_scc1 L_shift
L_base:
    s_and_b32 s27, s26, 0x7f000
    s_and_b32 s26, s26, 0x7fe00
    s_add_u32 s26, s26, s27
    s_lshl1_add_u32 s20, s26, s20
    s_load_dword s24, s[4:5], s20
    s_load_dword s25, s[4:5], s20 offset:0x2040
    global_load_dwordx4 v[4:7], v2, s[4:5] nt
    global_load_dwordx4 v[24:27], v1, s[6:7]
    s_mov_b32 s0, 0xffff0000
    s_mov_b32 s1, 0x3b000000
    v_mov_b32 v29, 0x358637bd
    s_lshr_b32 s14, s16, 8
    s_xor_b32 s14, s14, s16
    s_and_b32 s14, s14, 0x2000
    s_bitset1_b32 s14, 22
    s_xor_b32 s16, s16, s14
    s_and_b32 s18, s18, 3
    s_sub_u32 s18, s18, s2
    s_mov_b32 s13, 0
    s_mov_b32 s35, 0
    s_waitcnt lgkmcnt(1)
    s_cmp_lg_u32 s24, -16
    s_cselect_b32 s17, 0, 4
    s_add_u32 s34, s18, s17
    s_or_b32 s34, s34, 8
    s_cmp_ge_u32 s15, 8
    s_cbranch_scc1 L_go
    s_atomic_cmpswap s[34:35], s[10:11], 0
L_go:
    s_lshl_b32 s14, s17, 11
    s_xor_b32 s14, s14, s16
    v_or_b32 v3, s14, v1
    s_waitcnt vmcnt(1)
    global_load_dwordx4 v[8:11], v3, s[4:5] nt
    s_waitcnt vmcnt(1)
    v_lshlrev_b32 v12, 16, v24
    v_and_b32 v13, s0, v24
    v_lshlrev_b32 v14, 16, v25
    v_and_b32 v15, s0, v25
    v_lshlrev_b32 v16, 16, v26
    v_and_b32 v17, s0, v26
    v_lshlrev_b32 v18, 16, v27
    v_and_b32 v19, s0, v27
L_pass:
    ROW 4
    global_store_dwordx4 v2, v[4:7], s[8:9] sc1
    s_cmp_lg_u32 s13, 0
    s_cbranch_scc1 L_last
    v_xor_b32 v2, 0xc00000, v3
    s_waitcnt vmcnt(1)
    s_load_dword s3, s[10:11], 0
    s_waitcnt lgkmcnt(0)
    s_cmp_eq_u32 s3, 0
    s_cbranch_scc1 L_poll
L_have:
    s_add_u32 s3, s3, s2
    s_xor_b32 s3, s3, s17
    s_and_b32 s3, s3, 4
    s_cbranch_scc1 L_flip
    global_load_dwordx4 v[4:7], v2, s[4:5] nt
    s_branch L_rowb
L_flip:
    s_lshl_b32 s3, s3, 11
    v_xor_b32 v3, s3, v3
    v_xor_b32 v2, s3, v2
    global_load_dwordx4 v[8:11], v3, s[4:5] nt
    global_load_dwordx4 v[4:7], v2, s[4:5] nt
L_last:
    s_waitcnt vmcnt(1)
L_rowb:
    ROW 8
    global_store_dwordx4 v3, v[8:11], s[8:9] sc1
    s_cmp_lg_u32 s13, 0
    s_cbranch_scc1 L_done
    s_mov_b32 s13, 1
    v_xor_b32 v3, 0x400000, v2
    s_waitcnt vmcnt(1)
    global_load_dwordx4 v[8:11], v3, s[4:5] nt
    s_branch L_pass
L_done:
    s_endpgm

L_shift:
    s_sub_u32 s4, s4, s19
    s_sub_u32 s8, s8, s19
    s_subb_u32 s9, s9, 0
    s_cmp_lt_u32 s16, s19
    s_cselect_b32 s14, 0x1000000, 0
    v_or_b32 v2, s14, v2
    s_branch L_base

L_poll:
    s_mov_b32 s22, 64
    v_mov_b32 v20, 0
L_poll1:
    global_load_dword v28, v20, s[10:11] sc1
    s_waitcnt vmcnt(0)
    v_readfirstlane_b32 s3, v28
    s_cmp_lg_u32 s3, 0
    s_cbranch_scc1 L_have
    s_sub_u32 s22, s22, 1
    s_cmp_lg_u32 s22, 0
    s_cbranch_scc1 L_poll1
    s_mov_b32 s20, s34
    s_mov_b32 s21, 0
    s_atomic_cmpswap s[20:21], s[10:11], 0 glc
    s_waitcnt lgkmcnt(0)
    s_cmp_eq_u32 s20, 0
    s_cselect_b32 s3, s34, s20
    s_branch L_have
.section .rodata,"a"
.p2align 6
.amdhsa_kernel standalone__rmsnorm__sampling_kernel
  .amdhsa_next_free_vgpr 30
  .amdhsa_next_free_sgpr 40
  .amdhsa_accum_offset 32
  .amdhsa_group_segment_fixed_size 0
  .amdhsa_kernarg_size 40
  .amdhsa_user_sgpr_count 2
  .amdhsa_user_sgpr_kernarg_segment_ptr 1
  .amdhsa_system_sgpr_workgroup_id_x 1
  .amdhsa_float_denorm_mode_32 3
.end_amdhsa_kernel
```

```asm
; @launch grid=(256,1,1) block=(1024,1,1) lds=0
.amdgcn_target "amdgcn-amd-amdhsa--gfx950"
.text
.p2align 12
.globl standalone__rmsnorm__sampling_kernel
.p2align 8
.type standalone__rmsnorm__sampling_kernel,@function

.macro ROW x
    v_mov_b32 v28, 0
    v_dot2c_f32_bf16 v28, v[\x], v[\x]
    v_dot2c_f32_bf16 v28, v[\x+1], v[\x+1]
    v_dot2c_f32_bf16 v28, v[\x+2], v[\x+2]
    v_dot2c_f32_bf16 v28, v[\x+3], v[\x+3]
    v_lshlrev_b32 v20, 16, v[\x]
    v_and_b32 v21, s0, v[\x]
    v_lshlrev_b32 v22, 16, v[\x+1]
    v_add_f32_dpp v28, v28, v28 row_shr:1 row_mask:0xf bank_mask:0xf bound_ctrl:0
    v_and_b32 v23, s0, v[\x+1]
    v_lshlrev_b32 v24, 16, v[\x+2]
    v_add_f32_dpp v28, v28, v28 row_shr:2 row_mask:0xf bank_mask:0xf bound_ctrl:0
    v_and_b32 v25, s0, v[\x+2]
    v_lshlrev_b32 v26, 16, v[\x+3]
    v_add_f32_dpp v28, v28, v28 row_shr:4 row_mask:0xf bank_mask:0xf bound_ctrl:0
    v_and_b32 v27, s0, v[\x+3]
    v_pk_mul_f32 v[20:21], v[20:21], v[12:13]
    v_add_f32_dpp v28, v28, v28 row_shr:8 row_mask:0xf bank_mask:0xf bound_ctrl:0
    v_pk_mul_f32 v[22:23], v[22:23], v[14:15]
    v_pk_mul_f32 v[24:25], v[24:25], v[16:17]
    v_add_f32_dpp v28, v28, v28 row_bcast:15 row_mask:0xa bank_mask:0xf
    v_pk_mul_f32 v[26:27], v[26:27], v[18:19]
    s_nop 0
    v_add_f32_dpp v28, v28, v28 row_bcast:31 row_mask:0xc bank_mask:0xf
    v_fma_f32 v28, v28, s1, v29
    v_rsq_f32 v28, v28
    s_nop 0
    v_readlane_b32 s36, v28, 63
    s_nop 1
    v_pk_mul_f32 v[20:21], v[20:21], s[36:37] op_sel_hi:[1,0]
    v_pk_mul_f32 v[22:23], v[22:23], s[36:37] op_sel_hi:[1,0]
    v_pk_mul_f32 v[24:25], v[24:25], s[36:37] op_sel_hi:[1,0]
    v_pk_mul_f32 v[26:27], v[26:27], s[36:37] op_sel_hi:[1,0]
    v_cvt_pk_bf16_f32 v[\x], v20, v21
    v_cvt_pk_bf16_f32 v[\x+1], v22, v23
    v_cvt_pk_bf16_f32 v[\x+2], v24, v25
    v_cvt_pk_bf16_f32 v[\x+3], v26, v27
.endm

standalone__rmsnorm__sampling_kernel:
    s_load_dwordx8 s[4:11], s[0:1], 0
    s_memrealtime s[26:27]
    v_readfirstlane_b32 s12, v0
    s_getreg_b32 s18, hwreg(HW_REG_XCC_ID, 0, 3)
    v_and_b32 v1, 63, v0
    s_lshl2_add_u32 s15, s12, s2
    s_and_b32 s16, s15, 0x300
    s_lshl_b32 s16, s16, 7
    s_and_b32 s14, s15, 0x10
    s_lshl_b32 s14, s14, 8
    s_or_b32 s16, s16, s14
    s_and_b32 s14, s15, 0xc20
    s_lshl_b32 s14, s14, 9
    s_or_b32 s16, s16, s14
    s_and_b32 s14, s15, 0x3
    s_lshl_b32 s14, s14, 10
    s_or_b32 s16, s16, s14
    s_and_b32 s14, s15, 0xc4
    s_lshl_b32 s14, s14, 11
    s_or_b32 s16, s16, s14
    s_and_b32 s14, s15, 0x8
    s_lshl_b32 s14, s14, 18
    s_or_b32 s16, s16, s14
    v_lshlrev_b32 v1, 4, v1
    s_and_b32 s20, s18, 4
    s_lshl_b32 s20, s20, 10
    s_or_b32 s20, s20, 0xc00000
    v_or_b32 v2, s16, v1
    s_cmpk_ge_u32 s2, 256
    s_cbranch_scc1 L_done
    s_mov_b32 s24, -16
    s_waitcnt lgkmcnt(0)
    s_and_b32 s19, s4, 0x1ffc00
    s_cbranch_scc1 L_shift
L_base:
    s_bfe_u32 s26, s26, 0xa0009
    s_mul_i32 s26, s26, 0x4001
    s_and_b32 s26, s26, 0x1fc380
    s_or_b32 s20, s20, s26
    s_load_dword s24, s[4:5], s20
    s_load_dword s25, s[4:5], s20 offset:0x2040
    global_load_dwordx4 v[4:7], v2, s[4:5] nt
    global_load_dwordx4 v[24:27], v1, s[6:7]
    s_mov_b32 s0, 0xffff0000
    s_mov_b32 s1, 0x3b000000
    v_mov_b32 v29, 0x358637bd
    s_lshr_b32 s14, s16, 8
    s_xor_b32 s14, s14, s16
    s_and_b32 s14, s14, 0x2000
    s_bitset1_b32 s14, 22
    s_xor_b32 s16, s16, s14
    s_and_b32 s18, s18, 3
    s_sub_u32 s18, s18, s2
    s_mov_b32 s13, 0
    s_mov_b32 s35, 0
    s_waitcnt lgkmcnt(1)
    s_cmp_lg_u32 s24, -16
    s_cselect_b32 s17, 0, 4
    s_add_u32 s34, s18, s17
    s_or_b32 s34, s34, 8
    s_cmp_ge_u32 s15, 8
    s_cbranch_scc1 L_go
    s_and_b32 s14, s2, 3
    s_cbranch_scc0 L_go
    s_atomic_cmpswap s[34:35], s[10:11], 0
L_go:
    s_lshl_b32 s14, s17, 11
    s_xor_b32 s14, s14, s16
    v_or_b32 v3, s14, v1
    s_waitcnt vmcnt(1)
    global_load_dwordx4 v[8:11], v3, s[4:5] nt
    s_waitcnt vmcnt(1)
    v_lshlrev_b32 v12, 16, v24
    v_and_b32 v13, s0, v24
    v_lshlrev_b32 v14, 16, v25
    v_and_b32 v15, s0, v25
    v_lshlrev_b32 v16, 16, v26
    v_and_b32 v17, s0, v26
    v_lshlrev_b32 v18, 16, v27
    v_and_b32 v19, s0, v27
L_pass:
    ROW 4
    global_store_dwordx4 v2, v[4:7], s[8:9] sc1
    s_cmp_lg_u32 s13, 0
    s_cbranch_scc1 L_last
    v_xor_b32 v2, 0xc00000, v3
    s_waitcnt vmcnt(1)
    s_load_dword s3, s[10:11], 0
    s_waitcnt lgkmcnt(0)
    s_cmp_eq_u32 s3, 0
    s_cbranch_scc1 L_poll
L_have:
    s_add_u32 s3, s3, s2
    s_xor_b32 s3, s3, s17
    s_and_b32 s3, s3, 4
    s_cbranch_scc1 L_flip
    global_load_dwordx4 v[4:7], v2, s[4:5] nt
    s_branch L_rowb
L_flip:
    s_lshl_b32 s3, s3, 11
    v_xor_b32 v3, s3, v3
    v_xor_b32 v2, s3, v2
    global_load_dwordx4 v[8:11], v3, s[4:5] nt
    global_load_dwordx4 v[4:7], v2, s[4:5] nt
L_last:
    s_waitcnt vmcnt(1)
L_rowb:
    ROW 8
    global_store_dwordx4 v3, v[8:11], s[8:9] sc1
    s_cmp_lg_u32 s13, 0
    s_cbranch_scc1 L_done
    s_mov_b32 s13, 1
    v_xor_b32 v3, 0x400000, v2
    s_waitcnt vmcnt(1)
    global_load_dwordx4 v[8:11], v3, s[4:5] nt
    s_branch L_pass
L_done:
    s_endpgm

L_shift:
    s_sub_u32 s4, s4, s19
    s_sub_u32 s8, s8, s19
    s_subb_u32 s9, s9, 0
    s_cmp_lt_u32 s16, s19
    s_cselect_b32 s14, 0x1000000, 0
    v_or_b32 v2, s14, v2
    s_branch L_base

L_poll:
    s_mov_b32 s22, 64
    v_mov_b32 v20, 0
L_poll1:
    global_load_dword v28, v20, s[10:11] sc1
    s_waitcnt vmcnt(0)
    v_readfirstlane_b32 s3, v28
    s_cmp_lg_u32 s3, 0
    s_cbranch_scc1 L_have
    s_sub_u32 s22, s22, 1
    s_cmp_lg_u32 s22, 0
    s_cbranch_scc1 L_poll1
    s_mov_b32 s20, s34
    s_mov_b32 s21, 0
    s_atomic_cmpswap s[20:21], s[10:11], 0 glc
    s_waitcnt lgkmcnt(0)
    s_cmp_eq_u32 s20, 0
    s_cselect_b32 s3, s34, s20
    s_branch L_have
.section .rodata,"a"
.p2align 6
.amdhsa_kernel standalone__rmsnorm__sampling_kernel
  .amdhsa_next_free_vgpr 30
  .amdhsa_next_free_sgpr 40
  .amdhsa_accum_offset 32
  .amdhsa_group_segment_fixed_size 0
  .amdhsa_kernarg_size 40
  .amdhsa_user_sgpr_count 2
  .amdhsa_user_sgpr_kernarg_segment_ptr 1
  .amdhsa_system_sgpr_workgroup_id_x 1
  .amdhsa_float_denorm_mode_32 3
.end_amdhsa_kernel
```

```asm
; @launch grid=(256,1,1) block=(1024,1,1) lds=0
.amdgcn_target "amdgcn-amd-amdhsa--gfx950"
.text
.p2align 12
.globl standalone__rmsnorm__sampling_kernel
.p2align 8
.type standalone__rmsnorm__sampling_kernel,@function

.macro ROW x
    v_dot2_f32_bf16 v28, v[\x], v[\x], 0
    v_dot2_f32_bf16 v28, v[\x+1], v[\x+1], v28
    v_dot2_f32_bf16 v28, v[\x+2], v[\x+2], v28
    v_dot2_f32_bf16 v28, v[\x+3], v[\x+3], v28
    v_lshlrev_b32 v20, 16, v[\x]
    v_and_b32 v21, s0, v[\x]
    v_lshlrev_b32 v22, 16, v[\x+1]
    v_add_f32_dpp v28, v28, v28 row_shr:1 row_mask:0xf bank_mask:0xf bound_ctrl:0
    v_and_b32 v23, s0, v[\x+1]
    v_lshlrev_b32 v24, 16, v[\x+2]
    v_add_f32_dpp v28, v28, v28 row_shr:2 row_mask:0xf bank_mask:0xf bound_ctrl:0
    v_and_b32 v25, s0, v[\x+2]
    v_lshlrev_b32 v26, 16, v[\x+3]
    v_add_f32_dpp v28, v28, v28 row_shr:4 row_mask:0xf bank_mask:0xf bound_ctrl:0
    v_and_b32 v27, s0, v[\x+3]
    v_pk_mul_f32 v[20:21], v[20:21], v[12:13]
    v_add_f32_dpp v28, v28, v28 row_shr:8 row_mask:0xf bank_mask:0xf bound_ctrl:0
    v_pk_mul_f32 v[22:23], v[22:23], v[14:15]
    v_pk_mul_f32 v[24:25], v[24:25], v[16:17]
    v_add_f32_dpp v28, v28, v28 row_bcast:15 row_mask:0xa bank_mask:0xf
    v_pk_mul_f32 v[26:27], v[26:27], v[18:19]
    s_nop 0
    v_add_f32_dpp v28, v28, v28 row_bcast:31 row_mask:0xc bank_mask:0xf
    v_fma_f32 v28, v28, s1, v29
    v_rsq_f32 v28, v28
    s_nop 0
    v_readlane_b32 s36, v28, 63
    s_nop 1
    v_pk_mul_f32 v[20:21], v[20:21], s[36:37] op_sel_hi:[1,0]
    v_pk_mul_f32 v[22:23], v[22:23], s[36:37] op_sel_hi:[1,0]
    v_pk_mul_f32 v[24:25], v[24:25], s[36:37] op_sel_hi:[1,0]
    v_pk_mul_f32 v[26:27], v[26:27], s[36:37] op_sel_hi:[1,0]
    v_cvt_pk_bf16_f32 v[\x], v20, v21
    v_cvt_pk_bf16_f32 v[\x+1], v22, v23
    v_cvt_pk_bf16_f32 v[\x+2], v24, v25
    v_cvt_pk_bf16_f32 v[\x+3], v26, v27
.endm

standalone__rmsnorm__sampling_kernel:
    s_load_dwordx8 s[4:11], s[0:1], 0
    s_memrealtime s[26:27]
    v_readfirstlane_b32 s12, v0
    s_getreg_b32 s18, hwreg(HW_REG_XCC_ID, 0, 3)
    v_and_b32 v1, 63, v0
    s_lshl2_add_u32 s15, s12, s2
    s_and_b32 s16, s15, 0x300
    s_lshl_b32 s16, s16, 7
    s_and_b32 s14, s15, 0x810
    s_lshl_b32 s14, s14, 8
    s_or_b32 s16, s16, s14
    s_and_b32 s14, s15, 0x20
    s_lshl_b32 s14, s14, 9
    s_or_b32 s16, s16, s14
    s_and_b32 s14, s15, 0x403
    s_lshl_b32 s14, s14, 10
    s_or_b32 s16, s16, s14
    s_and_b32 s14, s15, 0xc4
    s_lshl_b32 s14, s14, 11
    s_or_b32 s16, s16, s14
    s_and_b32 s14, s15, 0x8
    s_lshl_b32 s14, s14, 18
    s_or_b32 s16, s16, s14
    v_lshlrev_b32 v1, 4, v1
    s_and_b32 s20, s18, 4
    s_lshl_b32 s20, s20, 10
    s_or_b32 s20, s20, 0xc00000
    v_or_b32 v2, s16, v1
    s_cmpk_ge_u32 s2, 256
    s_cbranch_scc1 L_done
    s_mov_b32 s24, -16
    s_waitcnt lgkmcnt(0)
    s_and_b32 s19, s4, 0x1ffc00
    s_cbranch_scc1 L_shift
L_base:
    s_bfe_u32 s26, s26, 0xa0009
    s_mul_i32 s26, s26, 0x4001
    s_and_b32 s26, s26, 0x1fc380
    s_or_b32 s20, s20, s26
    s_load_dword s24, s[4:5], s20
    s_load_dword s25, s[4:5], s20 offset:0x2040
    global_load_dwordx4 v[4:7], v2, s[4:5] nt
    global_load_dwordx4 v[24:27], v1, s[6:7]
    s_mov_b32 s0, 0xffff0000
    s_mov_b32 s1, 0x3b000000
    v_mov_b32 v29, 0x358637bd
    s_lshr_b32 s14, s16, 8
    s_xor_b32 s14, s14, s16
    s_and_b32 s14, s14, 0x2000
    s_xor_b32 s14, s14, 0x401000
    s_xor_b32 s16, s16, s14
    s_and_b32 s18, s18, 3
    s_sub_u32 s18, s18, s2
    s_mov_b32 s13, 0
    s_mov_b32 s35, 0
    s_waitcnt lgkmcnt(1)
    s_cmp_lg_u32 s24, -16
    s_cselect_b32 s17, 0, 4
    s_add_u32 s34, s18, s17
    s_or_b32 s34, s34, 8
    s_cmp_ge_u32 s15, 8
    s_cbranch_scc1 L_go
    s_and_b32 s14, s2, 3
    s_cbranch_scc0 L_go
    s_atomic_cmpswap s[34:35], s[10:11], 0
L_go:
    s_lshl_b32 s14, s17, 11
    s_xor_b32 s14, s14, s16
    v_or_b32 v3, s14, v1
    s_waitcnt vmcnt(1)
    global_load_dwordx4 v[8:11], v3, s[4:5] nt
    s_waitcnt vmcnt(1)
    v_lshlrev_b32 v12, 16, v24
    v_and_b32 v13, s0, v24
    v_lshlrev_b32 v14, 16, v25
    v_and_b32 v15, s0, v25
    v_lshlrev_b32 v16, 16, v26
    v_and_b32 v17, s0, v26
    v_lshlrev_b32 v18, 16, v27
    v_and_b32 v19, s0, v27
L_pass:
    ROW 4
    global_store_dwordx4 v2, v[4:7], s[8:9] sc1
    s_cmp_lg_u32 s13, 0
    s_cbranch_scc1 L_last
    v_xor_b32 v2, 0xc01000, v3
    s_waitcnt vmcnt(1)
    s_load_dword s3, s[10:11], 0
    s_waitcnt lgkmcnt(0)
    s_cmp_eq_u32 s3, 0
    s_cbranch_scc1 L_poll
L_have:
    s_add_u32 s3, s3, s2
    s_xor_b32 s3, s3, s17
    s_and_b32 s3, s3, 4
    s_cbranch_scc1 L_flip
    global_load_dwordx4 v[4:7], v2, s[4:5] nt
    s_branch L_rowb
L_flip:
    s_lshl_b32 s3, s3, 11
    v_xor_b32 v3, s3, v3
    v_xor_b32 v2, s3, v2
    global_load_dwordx4 v[8:11], v3, s[4:5] nt
    global_load_dwordx4 v[4:7], v2, s[4:5] nt
L_last:
    s_waitcnt vmcnt(1)
L_rowb:
    ROW 8
    global_store_dwordx4 v3, v[8:11], s[8:9] sc1
    s_cmp_lg_u32 s13, 0
    s_cbranch_scc1 L_done
    s_mov_b32 s13, 1
    v_xor_b32 v3, 0x400000, v2
    s_waitcnt vmcnt(1)
    global_load_dwordx4 v[8:11], v3, s[4:5] nt
    s_branch L_pass
L_done:
    s_endpgm

L_shift:
    s_sub_u32 s4, s4, s19
    s_sub_u32 s8, s8, s19
    s_subb_u32 s9, s9, 0
    s_cmp_lt_u32 s16, s19
    s_cselect_b32 s14, 0x1000000, 0
    v_or_b32 v2, s14, v2
    s_branch L_base

L_poll:
    s_mov_b32 s22, 64
    v_mov_b32 v20, 0
L_poll1:
    global_load_dword v28, v20, s[10:11] sc1
    s_waitcnt vmcnt(0)
    v_readfirstlane_b32 s3, v28
    s_cmp_lg_u32 s3, 0
    s_cbranch_scc1 L_have
    s_sub_u32 s22, s22, 1
    s_cmp_lg_u32 s22, 0
    s_cbranch_scc1 L_poll1
    s_mov_b32 s20, s34
    s_mov_b32 s21, 0
    s_atomic_cmpswap s[20:21], s[10:11], 0 glc
    s_waitcnt lgkmcnt(0)
    s_cmp_eq_u32 s20, 0
    s_cselect_b32 s3, s34, s20
    s_branch L_have
.section .rodata,"a"
.p2align 6
.amdhsa_kernel standalone__rmsnorm__sampling_kernel
  .amdhsa_next_free_vgpr 30
  .amdhsa_next_free_sgpr 40
  .amdhsa_accum_offset 32
  .amdhsa_group_segment_fixed_size 0
  .amdhsa_kernarg_size 40
  .amdhsa_user_sgpr_count 2
  .amdhsa_user_sgpr_kernarg_segment_ptr 1
  .amdhsa_system_sgpr_workgroup_id_x 1
  .amdhsa_float_denorm_mode_32 3
.end_amdhsa_kernel
```

```asm
; @launch grid=(256,1,1) block=(1024,1,1) lds=0
.amdgcn_target "amdgcn-amd-amdhsa--gfx950"
.text
.p2align 12
.globl standalone__rmsnorm__sampling_kernel
.p2align 8
.type standalone__rmsnorm__sampling_kernel,@function

.macro ROW x
    v_dot2_f32_bf16 v28, v[\x], v[\x], 0
    v_dot2_f32_bf16 v28, v[\x+1], v[\x+1], v28
    v_dot2_f32_bf16 v28, v[\x+2], v[\x+2], v28
    v_dot2_f32_bf16 v28, v[\x+3], v[\x+3], v28
    v_lshlrev_b32 v20, 16, v[\x]
    v_and_b32 v21, s0, v[\x]
    v_lshlrev_b32 v22, 16, v[\x+1]
    v_add_f32_dpp v28, v28, v28 row_shr:1 row_mask:0xf bank_mask:0xf bound_ctrl:0
    v_and_b32 v23, s0, v[\x+1]
    v_lshlrev_b32 v24, 16, v[\x+2]
    v_add_f32_dpp v28, v28, v28 row_shr:2 row_mask:0xf bank_mask:0xf bound_ctrl:0
    v_and_b32 v25, s0, v[\x+2]
    v_lshlrev_b32 v26, 16, v[\x+3]
    v_add_f32_dpp v28, v28, v28 row_shr:4 row_mask:0xf bank_mask:0xf bound_ctrl:0
    v_and_b32 v27, s0, v[\x+3]
    v_pk_mul_f32 v[20:21], v[20:21], v[12:13]
    v_add_f32_dpp v28, v28, v28 row_shr:8 row_mask:0xf bank_mask:0xf bound_ctrl:0
    v_pk_mul_f32 v[22:23], v[22:23], v[14:15]
    v_pk_mul_f32 v[24:25], v[24:25], v[16:17]
    v_add_f32_dpp v28, v28, v28 row_bcast:15 row_mask:0xa bank_mask:0xf
    v_pk_mul_f32 v[26:27], v[26:27], v[18:19]
    s_nop 0
    v_add_f32_dpp v28, v28, v28 row_bcast:31 row_mask:0xc bank_mask:0xf
    v_fma_f32 v28, v28, s1, v29
    v_rsq_f32 v28, v28
    s_nop 0
    v_readlane_b32 s36, v28, 63
    s_nop 1
    v_pk_mul_f32 v[20:21], v[20:21], s[36:37] op_sel_hi:[1,0]
    v_pk_mul_f32 v[22:23], v[22:23], s[36:37] op_sel_hi:[1,0]
    v_pk_mul_f32 v[24:25], v[24:25], s[36:37] op_sel_hi:[1,0]
    v_pk_mul_f32 v[26:27], v[26:27], s[36:37] op_sel_hi:[1,0]
    v_cvt_pk_bf16_f32 v[\x], v20, v21
    v_cvt_pk_bf16_f32 v[\x+1], v22, v23
    v_cvt_pk_bf16_f32 v[\x+2], v24, v25
    v_cvt_pk_bf16_f32 v[\x+3], v26, v27
.endm

standalone__rmsnorm__sampling_kernel:
    s_load_dwordx8 s[4:11], s[0:1], 0
    s_memrealtime s[26:27]
    v_readfirstlane_b32 s12, v0
    s_getreg_b32 s18, hwreg(HW_REG_XCC_ID, 0, 3)
    v_and_b32 v1, 63, v0
    s_lshl2_add_u32 s15, s12, s2
    s_and_b32 s16, s15, 0x300
    s_lshl_b32 s16, s16, 7
    s_and_b32 s14, s15, 0x810
    s_lshl_b32 s14, s14, 8
    s_or_b32 s16, s16, s14
    s_and_b32 s14, s15, 0x20
    s_lshl_b32 s14, s14, 9
    s_or_b32 s16, s16, s14
    s_and_b32 s14, s15, 0x403
    s_lshl_b32 s14, s14, 10
    s_or_b32 s16, s16, s14
    s_and_b32 s14, s15, 0xc4
    s_lshl_b32 s14, s14, 11
    s_or_b32 s16, s16, s14
    s_and_b32 s14, s15, 0x8
    s_lshl_b32 s14, s14, 18
    s_or_b32 s16, s16, s14
    v_lshlrev_b32 v1, 4, v1
    s_and_b32 s20, s18, 4
    s_lshl_b32 s20, s20, 10
    s_or_b32 s20, s20, 0xc00000
    v_or_b32 v2, s16, v1
    s_cmpk_ge_u32 s2, 256
    s_cbranch_scc1 L_done
    s_mov_b32 s24, -16
    s_waitcnt lgkmcnt(0)
    s_and_b32 s19, s4, 0x1ffc00
    s_cbranch_scc1 L_shift
L_base:
    s_bfe_u32 s26, s26, 0xa0009
    s_mul_i32 s26, s26, 0x4001
    s_and_b32 s26, s26, 0x1fc380
    s_or_b32 s20, s20, s26
    s_load_dword s24, s[4:5], s20
    s_load_dword s25, s[4:5], s20 offset:0x2040
    global_load_dwordx4 v[4:7], v2, s[4:5] nt
    global_load_dwordx4 v[24:27], v1, s[6:7]
    s_mov_b32 s0, 0xffff0000
    s_mov_b32 s1, 0x3b000000
    v_mov_b32 v29, 0x358637bd
    s_lshr_b32 s14, s16, 8
    s_xor_b32 s14, s14, s16
    s_and_b32 s14, s14, 0x2000
    s_xor_b32 s14, s14, 0x401000
    s_xor_b32 s16, s16, s14
    s_and_b32 s18, s18, 3
    s_sub_u32 s18, s18, s2
    s_mov_b32 s13, 0
    s_mov_b32 s35, 0
    s_waitcnt lgkmcnt(1)
    s_cmp_lg_u32 s24, -16
    s_cselect_b32 s17, 0, 4
    s_add_u32 s34, s18, s17
    s_or_b32 s34, s34, 8
    s_cmp_ge_u32 s15, 8
    s_cbranch_scc1 L_go
    s_and_b32 s14, s2, 3
    s_cbranch_scc0 L_go
    s_atomic_cmpswap s[34:35], s[10:11], 0
L_go:
    s_lshl_b32 s14, s17, 11
    s_xor_b32 s14, s14, s16
    v_or_b32 v3, s14, v1
    s_waitcnt vmcnt(1)
    global_load_dwordx4 v[8:11], v3, s[4:5] nt
    s_waitcnt vmcnt(1)
    v_lshlrev_b32 v12, 16, v24
    v_and_b32 v13, s0, v24
    v_lshlrev_b32 v14, 16, v25
    v_and_b32 v15, s0, v25
    v_lshlrev_b32 v16, 16, v26
    v_and_b32 v17, s0, v26
    v_lshlrev_b32 v18, 16, v27
    v_and_b32 v19, s0, v27
L_pass:
    ROW 4
    global_store_dwordx4 v2, v[4:7], s[8:9] sc1
    s_cmp_lg_u32 s13, 0
    s_cbranch_scc1 L_last
    v_xor_b32 v2, 0xc01000, v3
    s_waitcnt vmcnt(1)
    s_load_dword s3, s[10:11], 0
    s_waitcnt lgkmcnt(0)
    s_cmp_eq_u32 s3, 0
    s_cbranch_scc1 L_poll
L_have:
    s_add_u32 s3, s3, s2
    s_xor_b32 s3, s3, s17
    s_and_b32 s3, s3, 4
    s_cbranch_scc1 L_flip
    global_load_dwordx4 v[4:7], v2, s[4:5] nt
    s_branch L_rowb
L_last:
    s_waitcnt vmcnt(1)
L_rowb:
    ROW 8
    global_store_dwordx4 v3, v[8:11], s[8:9] sc1
    s_cmp_lg_u32 s13, 0
    s_cbranch_scc1 L_done
    s_mov_b32 s13, 1
    v_xor_b32 v3, 0x400000, v2
    s_waitcnt vmcnt(1)
    global_load_dwordx4 v[8:11], v3, s[4:5] nt
    s_branch L_pass
L_done:
    s_endpgm

L_flip:
    s_lshl_b32 s3, s3, 11
    v_xor_b32 v3, s3, v3
    v_xor_b32 v2, s3, v2
    global_load_dwordx4 v[8:11], v3, s[4:5] nt
    global_load_dwordx4 v[4:7], v2, s[4:5] nt
    s_branch L_last

L_shift:
    s_sub_u32 s4, s4, s19
    s_sub_u32 s8, s8, s19
    s_subb_u32 s9, s9, 0
    s_cmp_lt_u32 s16, s19
    s_cselect_b32 s14, 0x1000000, 0
    v_or_b32 v2, s14, v2
    s_branch L_base

L_poll:
    s_mov_b32 s22, 64
    v_mov_b32 v20, 0
L_poll1:
    global_load_dword v28, v20, s[10:11] sc1
    s_waitcnt vmcnt(0)
    v_readfirstlane_b32 s3, v28
    s_cmp_lg_u32 s3, 0
    s_cbranch_scc1 L_have
    s_sub_u32 s22, s22, 1
    s_cmp_lg_u32 s22, 0
    s_cbranch_scc1 L_poll1
    s_mov_b32 s20, s34
    s_mov_b32 s21, 0
    s_atomic_cmpswap s[20:21], s[10:11], 0 glc
    s_waitcnt lgkmcnt(0)
    s_cmp_eq_u32 s20, 0
    s_cselect_b32 s3, s34, s20
    s_branch L_have
.section .rodata,"a"
.p2align 6
.amdhsa_kernel standalone__rmsnorm__sampling_kernel
  .amdhsa_next_free_vgpr 30
  .amdhsa_next_free_sgpr 40
  .amdhsa_accum_offset 32
  .amdhsa_group_segment_fixed_size 0
  .amdhsa_kernarg_size 40
  .amdhsa_user_sgpr_count 2
  .amdhsa_user_sgpr_kernarg_segment_ptr 1
  .amdhsa_system_sgpr_workgroup_id_x 1
  .amdhsa_float_denorm_mode_32 3
.end_amdhsa_kernel
```
